```python
import torch

def _softmax(x, axis=-1):
    return torch.softmax(x, dim=axis)
def _gelu(x):
    return torch.nn.functional.gelu(x, approximate="tanh")
def _silu(x):
    return torch.nn.functional.silu(x)
def _sigmoid(x):
    return torch.sigmoid(x)
def _layernorm(x, axis=-1, eps=1e-5):
    m = x.mean(dim=axis, keepdim=True)
    v = x.var(dim=axis, keepdim=True, unbiased=False)
    return (x - m) / torch.sqrt(v + eps)
def _scatter_add(tgt, idx, src, axis=0):
    return tgt.clone().index_add_(axis, idx, src)
def _segment_sum(src, seg, n):
    out = torch.zeros((n,) + src.shape[1:], dtype=src.dtype)
    return out.index_add_(0, seg, src)
def _pad(x, pw):
    flat = tuple(v for pair in reversed(pw) for v in pair)
    return torch.nn.functional.pad(x, flat)

kernel_name = 'standalone__channel_attn_eca__vision'

def setup_inputs():

    _w = (lambda a: (lambda t: t.to(torch.bfloat16) if t.is_floating_point() else t)(torch.as_tensor(a)))
    H = W = 224
    C = 192
    k = 3
    return {
        "x": _w((lambda *s: torch.randn(*s, dtype=torch.bfloat16) * 0.4)(1, H, W, C) + (lambda *s: torch.randn(*s, dtype=torch.bfloat16) * 0.4)(1, 1, 1, C) * 2.0),
        "w1d": _w((lambda *s: torch.randn(*s, dtype=torch.bfloat16) * 0.4)(k)),
    }

def reference(x, w1d):
    B, H, W, C = x.shape
    k = 3
    pad = k // 2
    g = torch.einsum("bhwc->bc", x) / (H * W)
    gp = _pad(g, ((0, 0), (pad, pad)))
    s = torch.zeros_like(g)
    for i in range(k):
        s = s + gp[:, i:i + C] * w1d[i]
    s = _sigmoid(s)
    return x * s[:, None, None, :]
```

```asm
; @launch grid=(256,1,1) block=(192,1,1) lds=0
.amdgcn_target "amdgcn-amd-amdhsa--gfx950"
.text
.globl standalone__channel_attn_eca__vision_kernel
.p2align 8
.type standalone__channel_attn_eca__vision_kernel,@function
standalone__channel_attn_eca__vision_kernel:
    s_load_dwordx2 s[16:17], s[0:1], 0
    s_load_dwordx8 s[4:11], s[0:1], 8
    s_getpc_b64 s[52:53]
    v_lshlrev_b32 v6, 5, v0
    global_load_dword v51, v6, s[52:53]
    v_readfirstlane_b32 s3, v0
    v_and_b32 v4, 56, v0
    v_and_b32 v5, 7, v0
    v_mul_u32_u24 v4, 48, v4
    v_lshl_add_u32 v1, v5, 4, v4
    s_cmpk_ge_u32 s2, 256
    s_cbranch_scc1 L_end
    s_mul_i32 s34, s2, 75264
    s_mov_b32 s18, 19267584
    s_lshl1_add_u32 s34, s3, s34
    s_mov_b32 s19, 0x20000
    s_mov_b32 s40, s34
    s_cmpk_lt_u32 s3, 128
    s_cbranch_scc1 L_kwait
    s_and_b32 s32, s2, 7
    s_cbranch_scc1 L_nojob
    s_cmpk_ge_u32 s2, 48
    s_cbranch_scc1 L_nojob
    s_lshl_b32 s32, s2, 9
    v_lshl_add_u32 v7, v0, 4, s32
    v_mov_b64 v[12:13], 0
    v_mov_b64 v[14:15], 0
    s_waitcnt lgkmcnt(0)
    global_store_dwordx4 v7, v[12:15], s[10:11] offset:-2048 sc0 sc1
    global_store_dwordx4 v7, v[12:15], s[10:11] offset:-1024 sc0 sc1
    global_store_dwordx4 v7, v[12:15], s[10:11] offset:0 sc0 sc1
    global_store_dwordx4 v7, v[12:15], s[10:11] offset:1024 sc0 sc1
    s_branch L_job
L_kwait:
    s_waitcnt lgkmcnt(0)
L_loads:
    buffer_load_dwordx4 v[56:59], v1, s[16:19], s40 offen offset:0 nt
    buffer_load_dwordx4 v[60:63], v1, s[16:19], s40 offen offset:3072 nt
    s_addk_i32 s40, 6144
    buffer_load_dwordx4 v[64:67], v1, s[16:19], s40 offen offset:0 nt
    buffer_load_dwordx4 v[68:71], v1, s[16:19], s40 offen offset:3072 nt
    s_addk_i32 s40, 6144
    buffer_load_dwordx4 v[72:75], v1, s[16:19], s40 offen offset:0 nt
    buffer_load_dwordx4 v[76:79], v1, s[16:19], s40 offen offset:3072 nt
    s_addk_i32 s40, 6144
    buffer_load_dwordx4 v[80:83], v1, s[16:19], s40 offen offset:0 nt
    buffer_load_dwordx4 v[84:87], v1, s[16:19], s40 offen offset:3072 nt
    s_addk_i32 s40, 6144
    buffer_load_dwordx4 v[88:91], v1, s[16:19], s40 offen offset:0 nt
    buffer_load_dwordx4 v[92:95], v1, s[16:19], s40 offen offset:3072 nt
    s_addk_i32 s40, 6144
    buffer_load_dwordx4 v[96:99], v1, s[16:19], s40 offen offset:0 nt
    buffer_load_dwordx4 v[100:103], v1, s[16:19], s40 offen offset:3072 nt
    s_addk_i32 s40, 6144
    buffer_load_dwordx4 v[104:107], v1, s[16:19], s40 offen offset:0 nt
    buffer_load_dwordx4 v[108:111], v1, s[16:19], s40 offen offset:3072 nt
    s_addk_i32 s40, 6144
    buffer_load_dwordx4 v[112:115], v1, s[16:19], s40 offen offset:0 nt
    buffer_load_dwordx4 v[116:119], v1, s[16:19], s40 offen offset:3072 nt
    s_addk_i32 s40, 6144
    buffer_load_dwordx4 v[120:123], v1, s[16:19], s40 offen offset:0 nt
    buffer_load_dwordx4 v[124:127], v1, s[16:19], s40 offen offset:3072 nt
    s_addk_i32 s40, 6144
    buffer_load_dwordx4 v[128:131], v1, s[16:19], s40 offen offset:0 nt
    buffer_load_dwordx4 v[132:135], v1, s[16:19], s40 offen offset:3072 nt
    s_addk_i32 s40, 6144
    buffer_load_dwordx4 v[136:139], v1, s[16:19], s40 offen offset:0 nt
    buffer_load_dwordx4 v[140:143], v1, s[16:19], s40 offen offset:3072 nt
    s_addk_i32 s40, 6144
    v_and_b32 v6, 32, v0
    v_lshl_or_b32 v2, v6, 26, v1
    buffer_load_dwordx4 v[144:147], v1, s[16:19], s40 offen offset:0 nt
    buffer_load_dwordx4 v[148:151], v1, s[16:19], s40 offen offset:3072 nt
    s_addk_i32 s40, 6144
    buffer_load_dwordx4 v[152:155], v2, s[16:19], s40 offen nt
    v_mov_b32 v6, 0
    v_mov_b32 v48, 0
    v_mov_b32 v49, 0
    v_mov_b32 v50, 0
    global_load_short_d16_hi v48, v6, s[4:5]
    global_load_short_d16_hi v49, v6, s[4:5] offset:2
    global_load_short_d16_hi v50, v6, s[4:5] offset:4
    s_cmpk_eq_u32 s3, 128
    s_cbranch_scc1 L_setup
    s_barrier
    s_branch L_setup
L_job:
    s_mov_b32 s47, 1
    s_waitcnt vmcnt(0)
    s_atomic_add s47, s[8:9], 0
    s_atomic_add s47, s[8:9], 64
    s_atomic_add s47, s[8:9], 128
    s_atomic_add s47, s[8:9], 192
    s_branch L_jobdone
L_nojob:
    s_waitcnt lgkmcnt(0)
L_jobdone:
    s_barrier
    s_branch L_loads
L_setup:
    s_mov_b32 s20, s6
    s_mov_b32 s21, s7
    s_mov_b32 s22, s18
    s_mov_b32 s23, s19
    s_mov_b32 s24, s10
    s_mov_b32 s25, s11
    s_mov_b32 s26, 24576
    s_mov_b32 s27, s19
    s_mov_b32 s35, 0xffff0000
    s_mov_b32 s36, 0xaaaaaaaa
    s_mov_b32 s37, s36
    s_lshr_b32 s33, s2, 3
    s_xor_b32 s33, s33, s2
    s_bfe_u32 s32, s33, 0x20001
    s_and_b32 s33, s33, 1
    s_mul_i32 s32, s32, 6144
    s_lshl_b32 s33, s33, 6
    s_add_u32 s32, s32, s33
    s_lshl_b32 s33, s3, 5
    s_add_u32 s33, s33, s32
    v_bfe_u32 v6, v0, 4, 2
    v_and_b32 v7, 15, v0
    s_addk_i32 s32, 128
    v_lshl_add_u32 v44, v5, 8, s32
    v_lshlrev_b32 v7, 2, v7
    v_lshl_add_u32 v6, v6, 8, v7
    v_add_u32 v10, s33, v6
    v_lshrrev_b32 v6, 3, v0
    v_lshlrev_b32 v7, 3, v5
    v_lshl_add_u32 v54, v6, 8, v7
    v_bfe_u32 v7, v0, 5, 1
    v_mul_u32_u24 v7, 65, v7
    v_add3_u32 v7, v7, s3, -1
    v_cmp_gt_u32 vcc, 192, v7
    v_lshrrev_b32 v6, 3, v7
    v_and_b32 v7, 7, v7
    v_lshlrev_b32 v7, 3, v7
    v_lshl_add_u32 v7, v6, 8, v7
    v_cndmask_b32 v45, 0, -1, vcc
    v_lshlrev_b32 v55, 5, v5
    v_and_b32 v11, v45, v7
    v_lshrrev_b32 v6, 1, v5
    v_mul_u32_u24 v6, 6144, v6
    v_and_b32 v7, 1, v0
    v_lshl_add_u32 v6, v7, 6, v6
    v_add_u32 v11, v11, v6
    v_bfe_u32 v6, v0, 4, 2
    v_bfe_u32 v7, v0, 2, 2
    v_lshl_add_u32 v6, v7, 3, v6
    v_bfe_u32 v7, v0, 1, 1
    v_lshl_add_u32 v6, v7, 5, v6
    v_lshlrev_b32 v47, 2, v6
    s_and_b32 s54, s2, 7
    s_lshl_b32 s54, s54, 8
    s_add_u32 s54, s54, s32
    s_movk_i32 s38, 6144
    s_movk_i32 s39, 12288
    s_movk_i32 s41, 18432
    s_mov_b32 s48, 0x43800000
    s_mov_b32 s42, 0x37a72f05
    s_mov_b32 s43, 0xbfb8aa3b
    s_and_b32 s45, s3, 128
    s_mov_b32 s49, 2000000
    s_mov_b32 s46, s49
    s_waitcnt vmcnt(27)
    v_lshlrev_b32 v156, 16, v56
    v_and_b32 v56, s35, v56
    v_lshlrev_b32 v157, 16, v57
    v_and_b32 v57, s35, v57
    v_lshlrev_b32 v158, 16, v58
    v_and_b32 v58, s35, v58
    v_lshlrev_b32 v159, 16, v59
    v_and_b32 v59, s35, v59
    s_waitcnt vmcnt(26)
    v_lshlrev_b32 v160, 16, v60
    v_and_b32 v60, s35, v60
    v_lshlrev_b32 v161, 16, v61
    v_and_b32 v61, s35, v61
    v_lshlrev_b32 v162, 16, v62
    v_and_b32 v62, s35, v62
    v_lshlrev_b32 v163, 16, v63
    v_and_b32 v63, s35, v63
    v_pk_add_f32 v[12:13], v[156:157], v[160:161]
    v_pk_add_f32 v[16:17], v[56:57], v[60:61]
    v_pk_add_f32 v[14:15], v[158:159], v[162:163]
    v_pk_add_f32 v[18:19], v[58:59], v[62:63]
    s_waitcnt vmcnt(25)
    v_lshlrev_b32 v164, 16, v64
    v_and_b32 v64, s35, v64
    v_lshlrev_b32 v165, 16, v65
    v_and_b32 v65, s35, v65
    v_lshlrev_b32 v166, 16, v66
    v_and_b32 v66, s35, v66
    v_lshlrev_b32 v167, 16, v67
    v_and_b32 v67, s35, v67
    v_pk_add_f32 v[12:13], v[12:13], v[164:165]
    v_pk_add_f32 v[16:17], v[16:17], v[64:65]
    v_pk_add_f32 v[14:15], v[14:15], v[166:167]
    v_pk_add_f32 v[18:19], v[18:19], v[66:67]
    s_waitcnt vmcnt(24)
    v_lshlrev_b32 v168, 16, v68
    v_and_b32 v68, s35, v68
    v_lshlrev_b32 v169, 16, v69
    v_and_b32 v69, s35, v69
    v_lshlrev_b32 v170, 16, v70
    v_and_b32 v70, s35, v70
    v_lshlrev_b32 v171, 16, v71
    v_and_b32 v71, s35, v71
    v_pk_add_f32 v[12:13], v[12:13], v[168:169]
    v_pk_add_f32 v[16:17], v[16:17], v[68:69]
    v_pk_add_f32 v[14:15], v[14:15], v[170:171]
    v_pk_add_f32 v[18:19], v[18:19], v[70:71]
    s_waitcnt vmcnt(23)
    v_lshlrev_b32 v172, 16, v72
    v_and_b32 v72, s35, v72
    v_lshlrev_b32 v173, 16, v73
    v_and_b32 v73, s35, v73
    v_lshlrev_b32 v174, 16, v74
    v_and_b32 v74, s35, v74
    v_lshlrev_b32 v175, 16, v75
    v_and_b32 v75, s35, v75
    v_pk_add_f32 v[12:13], v[12:13], v[172:173]
    v_pk_add_f32 v[16:17], v[16:17], v[72:73]
    v_pk_add_f32 v[14:15], v[14:15], v[174:175]
    v_pk_add_f32 v[18:19], v[18:19], v[74:75]
    s_waitcnt vmcnt(22)
    v_lshlrev_b32 v176, 16, v76
    v_and_b32 v76, s35, v76
    v_lshlrev_b32 v177, 16, v77
    v_and_b32 v77, s35, v77
    v_lshlrev_b32 v178, 16, v78
    v_and_b32 v78, s35, v78
    v_lshlrev_b32 v179, 16, v79
    v_and_b32 v79, s35, v79
    v_pk_add_f32 v[12:13], v[12:13], v[176:177]
    v_pk_add_f32 v[16:17], v[16:17], v[76:77]
    v_pk_add_f32 v[14:15], v[14:15], v[178:179]
    v_pk_add_f32 v[18:19], v[18:19], v[78:79]
    s_waitcnt vmcnt(21)
    v_lshlrev_b32 v180, 16, v80
    v_and_b32 v80, s35, v80
    v_lshlrev_b32 v181, 16, v81
    v_and_b32 v81, s35, v81
    v_lshlrev_b32 v182, 16, v82
    v_and_b32 v82, s35, v82
    v_lshlrev_b32 v183, 16, v83
    v_and_b32 v83, s35, v83
    v_pk_add_f32 v[12:13], v[12:13], v[180:181]
    v_pk_add_f32 v[16:17], v[16:17], v[80:81]
    v_pk_add_f32 v[14:15], v[14:15], v[182:183]
    v_pk_add_f32 v[18:19], v[18:19], v[82:83]
    s_waitcnt vmcnt(20)
    v_lshlrev_b32 v184, 16, v84
    v_and_b32 v84, s35, v84
    v_lshlrev_b32 v185, 16, v85
    v_and_b32 v85, s35, v85
    v_lshlrev_b32 v186, 16, v86
    v_and_b32 v86, s35, v86
    v_lshlrev_b32 v187, 16, v87
    v_and_b32 v87, s35, v87
    v_pk_add_f32 v[12:13], v[12:13], v[184:185]
    v_pk_add_f32 v[16:17], v[16:17], v[84:85]
    v_pk_add_f32 v[14:15], v[14:15], v[186:187]
    v_pk_add_f32 v[18:19], v[18:19], v[86:87]
    s_waitcnt vmcnt(19)
    v_lshlrev_b32 v188, 16, v88
    v_and_b32 v88, s35, v88
    v_lshlrev_b32 v189, 16, v89
    v_and_b32 v89, s35, v89
    v_lshlrev_b32 v190, 16, v90
    v_and_b32 v90, s35, v90
    v_lshlrev_b32 v191, 16, v91
    v_and_b32 v91, s35, v91
    v_pk_add_f32 v[12:13], v[12:13], v[188:189]
    v_pk_add_f32 v[16:17], v[16:17], v[88:89]
    v_pk_add_f32 v[14:15], v[14:15], v[190:191]
    v_pk_add_f32 v[18:19], v[18:19], v[90:91]
    s_waitcnt vmcnt(18)
    v_lshlrev_b32 v192, 16, v92
    v_and_b32 v92, s35, v92
    v_lshlrev_b32 v193, 16, v93
    v_and_b32 v93, s35, v93
    v_lshlrev_b32 v194, 16, v94
    v_and_b32 v94, s35, v94
    v_lshlrev_b32 v195, 16, v95
    v_and_b32 v95, s35, v95
    v_pk_add_f32 v[12:13], v[12:13], v[192:193]
    v_pk_add_f32 v[16:17], v[16:17], v[92:93]
    v_pk_add_f32 v[14:15], v[14:15], v[194:195]
    v_pk_add_f32 v[18:19], v[18:19], v[94:95]
    s_waitcnt vmcnt(17)
    v_lshlrev_b32 v196, 16, v96
    v_and_b32 v96, s35, v96
    v_lshlrev_b32 v197, 16, v97
    v_and_b32 v97, s35, v97
    v_lshlrev_b32 v198, 16, v98
    v_and_b32 v98, s35, v98
    v_lshlrev_b32 v199, 16, v99
    v_and_b32 v99, s35, v99
    v_pk_add_f32 v[12:13], v[12:13], v[196:197]
    v_pk_add_f32 v[16:17], v[16:17], v[96:97]
    v_pk_add_f32 v[14:15], v[14:15], v[198:199]
    v_pk_add_f32 v[18:19], v[18:19], v[98:99]
    s_waitcnt vmcnt(16)
    v_lshlrev_b32 v200, 16, v100
    v_and_b32 v100, s35, v100
    v_lshlrev_b32 v201, 16, v101
    v_and_b32 v101, s35, v101
    v_lshlrev_b32 v202, 16, v102
    v_and_b32 v102, s35, v102
    v_lshlrev_b32 v203, 16, v103
    v_and_b32 v103, s35, v103
    v_pk_add_f32 v[12:13], v[12:13], v[200:201]
    v_pk_add_f32 v[16:17], v[16:17], v[100:101]
    v_pk_add_f32 v[14:15], v[14:15], v[202:203]
    v_pk_add_f32 v[18:19], v[18:19], v[102:103]
    s_waitcnt vmcnt(15)
    v_lshlrev_b32 v204, 16, v104
    v_and_b32 v104, s35, v104
    v_lshlrev_b32 v205, 16, v105
    v_and_b32 v105, s35, v105
    v_lshlrev_b32 v206, 16, v106
    v_and_b32 v106, s35, v106
    v_lshlrev_b32 v207, 16, v107
    v_and_b32 v107, s35, v107
    v_pk_add_f32 v[12:13], v[12:13], v[204:205]
    v_pk_add_f32 v[16:17], v[16:17], v[104:105]
    v_pk_add_f32 v[14:15], v[14:15], v[206:207]
    v_pk_add_f32 v[18:19], v[18:19], v[106:107]
    s_waitcnt vmcnt(14)
    v_lshlrev_b32 v208, 16, v108
    v_and_b32 v108, s35, v108
    v_lshlrev_b32 v209, 16, v109
    v_and_b32 v109, s35, v109
    v_lshlrev_b32 v210, 16, v110
    v_and_b32 v110, s35, v110
    v_lshlrev_b32 v211, 16, v111
    v_and_b32 v111, s35, v111
    v_pk_add_f32 v[12:13], v[12:13], v[208:209]
    v_pk_add_f32 v[16:17], v[16:17], v[108:109]
    v_pk_add_f32 v[14:15], v[14:15], v[210:211]
    v_pk_add_f32 v[18:19], v[18:19], v[110:111]
    s_waitcnt vmcnt(13)
    v_lshlrev_b32 v212, 16, v112
    v_and_b32 v112, s35, v112
    v_lshlrev_b32 v213, 16, v113
    v_and_b32 v113, s35, v113
    v_lshlrev_b32 v214, 16, v114
    v_and_b32 v114, s35, v114
    v_lshlrev_b32 v215, 16, v115
    v_and_b32 v115, s35, v115
    v_pk_add_f32 v[12:13], v[12:13], v[212:213]
    v_pk_add_f32 v[16:17], v[16:17], v[112:113]
    v_pk_add_f32 v[14:15], v[14:15], v[214:215]
    v_pk_add_f32 v[18:19], v[18:19], v[114:115]
    s_waitcnt vmcnt(12)
    v_lshlrev_b32 v216, 16, v116
    v_and_b32 v116, s35, v116
    v_lshlrev_b32 v217, 16, v117
    v_and_b32 v117, s35, v117
    v_lshlrev_b32 v218, 16, v118
    v_and_b32 v118, s35, v118
    v_lshlrev_b32 v219, 16, v119
    v_and_b32 v119, s35, v119
    v_pk_add_f32 v[12:13], v[12:13], v[216:217]
    v_pk_add_f32 v[16:17], v[16:17], v[116:117]
    v_pk_add_f32 v[14:15], v[14:15], v[218:219]
    v_pk_add_f32 v[18:19], v[18:19], v[118:119]
    s_waitcnt vmcnt(11)
    v_lshlrev_b32 v220, 16, v120
    v_and_b32 v120, s35, v120
    v_lshlrev_b32 v221, 16, v121
    v_and_b32 v121, s35, v121
    v_lshlrev_b32 v222, 16, v122
    v_and_b32 v122, s35, v122
    v_lshlrev_b32 v223, 16, v123
    v_and_b32 v123, s35, v123
    v_pk_add_f32 v[12:13], v[12:13], v[220:221]
    v_pk_add_f32 v[16:17], v[16:17], v[120:121]
    v_pk_add_f32 v[14:15], v[14:15], v[222:223]
    v_pk_add_f32 v[18:19], v[18:19], v[122:123]
    s_waitcnt vmcnt(10)
    v_lshlrev_b32 v224, 16, v124
    v_and_b32 v124, s35, v124
    v_lshlrev_b32 v225, 16, v125
    v_and_b32 v125, s35, v125
    v_lshlrev_b32 v226, 16, v126
    v_and_b32 v126, s35, v126
    v_lshlrev_b32 v227, 16, v127
    v_and_b32 v127, s35, v127
    v_pk_add_f32 v[12:13], v[12:13], v[224:225]
    v_pk_add_f32 v[16:17], v[16:17], v[124:125]
    v_pk_add_f32 v[14:15], v[14:15], v[226:227]
    v_pk_add_f32 v[18:19], v[18:19], v[126:127]
    s_waitcnt vmcnt(9)
    v_lshlrev_b32 v228, 16, v128
    v_and_b32 v128, s35, v128
    v_lshlrev_b32 v229, 16, v129
    v_and_b32 v129, s35, v129
    v_lshlrev_b32 v230, 16, v130
    v_and_b32 v130, s35, v130
    v_lshlrev_b32 v231, 16, v131
    v_and_b32 v131, s35, v131
    v_pk_add_f32 v[12:13], v[12:13], v[228:229]
    v_pk_add_f32 v[16:17], v[16:17], v[128:129]
    v_pk_add_f32 v[14:15], v[14:15], v[230:231]
    v_pk_add_f32 v[18:19], v[18:19], v[130:131]
    s_waitcnt vmcnt(8)
    v_lshlrev_b32 v232, 16, v132
    v_and_b32 v132, s35, v132
    v_lshlrev_b32 v233, 16, v133
    v_and_b32 v133, s35, v133
    v_lshlrev_b32 v234, 16, v134
    v_and_b32 v134, s35, v134
    v_lshlrev_b32 v235, 16, v135
    v_and_b32 v135, s35, v135
    v_pk_add_f32 v[12:13], v[12:13], v[232:233]
    v_pk_add_f32 v[16:17], v[16:17], v[132:133]
    v_pk_add_f32 v[14:15], v[14:15], v[234:235]
    v_pk_add_f32 v[18:19], v[18:19], v[134:135]
    s_load_dword s44, s[8:9], s45
    s_waitcnt vmcnt(7)
    v_lshlrev_b32 v236, 16, v136
    v_and_b32 v136, s35, v136
    v_lshlrev_b32 v237, 16, v137
    v_and_b32 v137, s35, v137
    v_lshlrev_b32 v238, 16, v138
    v_and_b32 v138, s35, v138
    v_lshlrev_b32 v239, 16, v139
    v_and_b32 v139, s35, v139
    v_pk_add_f32 v[12:13], v[12:13], v[236:237]
    v_pk_add_f32 v[16:17], v[16:17], v[136:137]
    v_pk_add_f32 v[14:15], v[14:15], v[238:239]
    v_pk_add_f32 v[18:19], v[18:19], v[138:139]
    s_waitcnt vmcnt(6)
    v_lshlrev_b32 v240, 16, v140
    v_and_b32 v140, s35, v140
    v_lshlrev_b32 v241, 16, v141
    v_and_b32 v141, s35, v141
    v_lshlrev_b32 v242, 16, v142
    v_and_b32 v142, s35, v142
    v_lshlrev_b32 v243, 16, v143
    v_and_b32 v143, s35, v143
    v_pk_add_f32 v[12:13], v[12:13], v[240:241]
    v_pk_add_f32 v[16:17], v[16:17], v[140:141]
    v_pk_add_f32 v[14:15], v[14:15], v[242:243]
    v_pk_add_f32 v[18:19], v[18:19], v[142:143]
    s_waitcnt vmcnt(5)
    v_lshlrev_b32 v244, 16, v144
    v_and_b32 v144, s35, v144
    v_lshlrev_b32 v245, 16, v145
    v_and_b32 v145, s35, v145
    v_lshlrev_b32 v246, 16, v146
    v_and_b32 v146, s35, v146
    v_lshlrev_b32 v247, 16, v147
    v_and_b32 v147, s35, v147
    v_pk_add_f32 v[12:13], v[12:13], v[244:245]
    v_pk_add_f32 v[16:17], v[16:17], v[144:145]
    v_pk_add_f32 v[14:15], v[14:15], v[246:247]
    v_pk_add_f32 v[18:19], v[18:19], v[146:147]
    s_waitcnt vmcnt(4)
    v_lshlrev_b32 v248, 16, v148
    v_and_b32 v148, s35, v148
    v_lshlrev_b32 v249, 16, v149
    v_and_b32 v149, s35, v149
    v_lshlrev_b32 v250, 16, v150
    v_and_b32 v150, s35, v150
    v_lshlrev_b32 v251, 16, v151
    v_and_b32 v151, s35, v151
    v_pk_add_f32 v[12:13], v[12:13], v[248:249]
    v_pk_add_f32 v[16:17], v[16:17], v[148:149]
    v_pk_add_f32 v[14:15], v[14:15], v[250:251]
    v_pk_add_f32 v[18:19], v[18:19], v[150:151]
    s_waitcnt vmcnt(3)
    v_lshlrev_b32 v252, 16, v152
    v_and_b32 v152, s35, v152
    v_lshlrev_b32 v253, 16, v153
    v_and_b32 v153, s35, v153
    v_lshlrev_b32 v254, 16, v154
    v_and_b32 v154, s35, v154
    v_lshlrev_b32 v255, 16, v155
    v_and_b32 v155, s35, v155
    v_pk_add_f32 v[12:13], v[12:13], v[252:253]
    v_pk_add_f32 v[16:17], v[16:17], v[152:153]
    v_pk_add_f32 v[14:15], v[14:15], v[254:255]
    v_pk_add_f32 v[18:19], v[18:19], v[154:155]
    s_nop 0
    v_permlane32_swap_b32 v12, v16
    v_permlane32_swap_b32 v13, v17
    v_permlane32_swap_b32 v14, v18
    v_permlane32_swap_b32 v15, v19
    v_pk_add_f32 v[12:13], v[12:13], v[16:17]
    v_pk_add_f32 v[14:15], v[14:15], v[18:19]
    s_waitcnt lgkmcnt(0)
    s_cmp_ge_u32 s44, 6
    v_permlane16_swap_b32 v12, v14
    v_permlane16_swap_b32 v13, v15
    v_pk_add_f32 v[12:13], v[12:13], v[14:15]
    s_cbranch_scc0 L_flagnext
L_flagok:
    s_nop 0
    v_add_f32_dpp v6, v12, v12 row_ror:8 row_mask:0xf bank_mask:0x3
    v_add_f32_dpp v6, v13, v13 row_ror:8 row_mask:0xf bank_mask:0xc
    ds_bpermute_b32 v4, v47, v6
    ds_bpermute_b32 v5, v47, v6 offset:16
    s_waitcnt lgkmcnt(1)
    v_cndmask_b32 v4, v4, 1.0, s[36:37]
    buffer_atomic_add_f32 v4, v10, s[24:27], 0 offen
    s_waitcnt lgkmcnt(0)
    v_cndmask_b32 v5, v5, 1.0, s[36:37]
    buffer_atomic_add_f32 v5, v10, s[24:27], 0 offen offset:1024
    s_cmp_eq_u32 s3, 0
    s_cbranch_scc1 L_probe
    s_cmp_lg_u32 s3, 64
    s_cbranch_scc1 L_bar
    s_mov_b64 exec, 0xff
    v_mov_b32 v9, 1
    buffer_atomic_add v9, v44, s[24:27], 0 offen
    s_mov_b64 exec, -1
L_bar:
    s_barrier
    s_branch L_poll
L_probe:
    s_mov_b32 s50, 0
    s_atomic_add s50, s[10:11], s54 glc
    s_sub_u32 s46, s46, 1
    s_cbranch_scc1 L_probex
    s_waitcnt lgkmcnt(0)
    s_cmp_lt_u32 s50, 32
    s_cbranch_scc1 L_probe
L_probex:
    s_mov_b32 s46, s49
L_repoll:
L_poll:
    buffer_load_dwordx2 v[22:23], v11, s[24:27], 0 offen sc1
    buffer_load_dwordx2 v[28:29], v54, s[24:27], 0 offen offset:0 sc1
    buffer_load_dwordx2 v[30:31], v54, s[24:27], 0 offen offset:64 sc1
    buffer_load_dwordx2 v[32:33], v54, s[24:27], s38 offen offset:0 sc1
    buffer_load_dwordx2 v[34:35], v54, s[24:27], s38 offen offset:64 sc1
    buffer_load_dwordx2 v[36:37], v54, s[24:27], s39 offen offset:0 sc1
    buffer_load_dwordx2 v[38:39], v54, s[24:27], s39 offen offset:64 sc1
    buffer_load_dwordx2 v[40:41], v54, s[24:27], s41 offen offset:0 sc1
    buffer_load_dwordx2 v[42:43], v54, s[24:27], s41 offen offset:64 sc1
    s_sub_u32 s46, s46, 1
    s_cbranch_scc1 L_polldone
    s_waitcnt vmcnt(8)
    v_add_f32_dpp v22, v22, v22 quad_perm:[1,0,3,2] row_mask:0xf bank_mask:0xf
    v_add_f32_dpp v23, v23, v23 quad_perm:[1,0,3,2] row_mask:0xf bank_mask:0xf
    s_waitcnt vmcnt(6)
    v_pk_add_f32 v[28:29], v[28:29], v[30:31]
    v_add_f32_dpp v22, v22, v22 quad_perm:[2,3,0,1] row_mask:0xf bank_mask:0xf
    v_add_f32_dpp v23, v23, v23 quad_perm:[2,3,0,1] row_mask:0xf bank_mask:0xf
    s_waitcnt vmcnt(4)
    v_pk_add_f32 v[32:33], v[32:33], v[34:35]
    v_add_f32_dpp v22, v22, v22 row_half_mirror row_mask:0xf bank_mask:0xf
    v_add_f32_dpp v23, v23, v23 row_half_mirror row_mask:0xf bank_mask:0xf
    v_pk_add_f32 v[28:29], v[28:29], v[32:33]
    s_waitcnt vmcnt(2)
    v_pk_add_f32 v[36:37], v[36:37], v[38:39]
    s_waitcnt vmcnt(0)
    v_pk_add_f32 v[40:41], v[40:41], v[42:43]
    v_pk_add_f32 v[36:37], v[36:37], v[40:41]
    v_pk_add_f32 v[20:21], v[28:29], v[36:37]
    v_min_f32 v44, v21, v23
    v_cvt_pk_bf16_f32 v20, 0, v20
    v_cmp_neq_f32 vcc, s48, v44
    v_cvt_pk_bf16_f32 v21, 0, v22
    s_cbranch_vccnz L_repoll
L_polldone:
    v_mul_f32 v20, s42, v20
    v_mul_f32 v21, s42, v21
    v_cvt_pk_bf16_f32 v20, 0, v20
    v_cvt_pk_bf16_f32 v21, 0, v21
    v_mul_f32 v23, v20, v49
    v_and_b32 v21, v45, v21
    v_cvt_pk_bf16_f32 v23, 0, v23
    v_mul_f32 v22, v21, v50
    v_mul_f32 v21, v21, v48
    s_nop 0
    v_mul_f32_dpp v22, v20, v50 wave_shl:1 row_mask:0xf bank_mask:0xf
    v_mul_f32_dpp v21, v20, v48 wave_shr:1 row_mask:0xf bank_mask:0xf
    v_cvt_pk_bf16_f32 v22, 0, v22
    v_cvt_pk_bf16_f32 v21, 0, v21
    v_add_f32 v20, v21, v23
    v_cvt_pk_bf16_f32 v20, 0, v20
    v_add_f32 v20, v20, v22
    v_cvt_pk_bf16_f32 v20, 0, v20
    v_mul_f32 v20, s43, v20
    v_exp_f32 v20, v20
    s_nop 0
    v_add_f32 v20, 1.0, v20
    v_rcp_f32 v20, v20
    s_mov_b32 s40, s34
    v_cvt_pk_bf16_f32 v46, 0, v20
    ds_bpermute_b32 v20, v55, v46 offset:0
    ds_bpermute_b32 v24, v55, v46 offset:4
    ds_bpermute_b32 v21, v55, v46 offset:8
    ds_bpermute_b32 v25, v55, v46 offset:12
    ds_bpermute_b32 v22, v55, v46 offset:16
    ds_bpermute_b32 v26, v55, v46 offset:20
    ds_bpermute_b32 v23, v55, v46 offset:24
    ds_bpermute_b32 v27, v55, v46 offset:28
    s_waitcnt lgkmcnt(4)
    v_pk_mul_f32 v[156:157], v[156:157], v[20:21]
    v_pk_mul_f32 v[56:57], v[56:57], v[24:25]
    s_waitcnt lgkmcnt(0)
    v_pk_mul_f32 v[158:159], v[158:159], v[22:23]
    v_pk_mul_f32 v[58:59], v[58:59], v[26:27]
    v_cvt_pk_bf16_f32 v56, v156, v56
    v_cvt_pk_bf16_f32 v57, v157, v57
    v_cvt_pk_bf16_f32 v58, v158, v58
    v_cvt_pk_bf16_f32 v59, v159, v59
    buffer_store_dwordx4 v[56:59], v1, s[20:23], s40 offen offset:0 sc1
    v_pk_mul_f32 v[160:161], v[160:161], v[20:21]
    v_pk_mul_f32 v[60:61], v[60:61], v[24:25]
    v_pk_mul_f32 v[162:163], v[162:163], v[22:23]
    v_pk_mul_f32 v[62:63], v[62:63], v[26:27]
    v_cvt_pk_bf16_f32 v60, v160, v60
    v_cvt_pk_bf16_f32 v61, v161, v61
    v_cvt_pk_bf16_f32 v62, v162, v62
    v_cvt_pk_bf16_f32 v63, v163, v63
    buffer_store_dwordx4 v[60:63], v1, s[20:23], s40 offen offset:3072 sc1
    s_addk_i32 s40, 6144
    v_pk_mul_f32 v[164:165], v[164:165], v[20:21]
    v_pk_mul_f32 v[64:65], v[64:65], v[24:25]
    v_pk_mul_f32 v[166:167], v[166:167], v[22:23]
    v_pk_mul_f32 v[66:67], v[66:67], v[26:27]
    v_cvt_pk_bf16_f32 v64, v164, v64
    v_cvt_pk_bf16_f32 v65, v165, v65
    v_cvt_pk_bf16_f32 v66, v166, v66
    v_cvt_pk_bf16_f32 v67, v167, v67
    buffer_store_dwordx4 v[64:67], v1, s[20:23], s40 offen offset:0 sc1
    v_pk_mul_f32 v[168:169], v[168:169], v[20:21]
    v_pk_mul_f32 v[68:69], v[68:69], v[24:25]
    v_pk_mul_f32 v[170:171], v[170:171], v[22:23]
    v_pk_mul_f32 v[70:71], v[70:71], v[26:27]
    v_cvt_pk_bf16_f32 v68, v168, v68
    v_cvt_pk_bf16_f32 v69, v169, v69
    v_cvt_pk_bf16_f32 v70, v170, v70
    v_cvt_pk_bf16_f32 v71, v171, v71
    buffer_store_dwordx4 v[68:71], v1, s[20:23], s40 offen offset:3072 sc1
    s_addk_i32 s40, 6144
    v_pk_mul_f32 v[172:173], v[172:173], v[20:21]
    v_pk_mul_f32 v[72:73], v[72:73], v[24:25]
    v_pk_mul_f32 v[174:175], v[174:175], v[22:23]
    v_pk_mul_f32 v[74:75], v[74:75], v[26:27]
    v_cvt_pk_bf16_f32 v72, v172, v72
    v_cvt_pk_bf16_f32 v73, v173, v73
    v_cvt_pk_bf16_f32 v74, v174, v74
    v_cvt_pk_bf16_f32 v75, v175, v75
    buffer_store_dwordx4 v[72:75], v1, s[20:23], s40 offen offset:0 sc1
    v_pk_mul_f32 v[176:177], v[176:177], v[20:21]
    v_pk_mul_f32 v[76:77], v[76:77], v[24:25]
    v_pk_mul_f32 v[178:179], v[178:179], v[22:23]
    v_pk_mul_f32 v[78:79], v[78:79], v[26:27]
    v_cvt_pk_bf16_f32 v76, v176, v76
    v_cvt_pk_bf16_f32 v77, v177, v77
    v_cvt_pk_bf16_f32 v78, v178, v78
    v_cvt_pk_bf16_f32 v79, v179, v79
    buffer_store_dwordx4 v[76:79], v1, s[20:23], s40 offen offset:3072 sc1
    s_addk_i32 s40, 6144
    v_pk_mul_f32 v[180:181], v[180:181], v[20:21]
    v_pk_mul_f32 v[80:81], v[80:81], v[24:25]
    v_pk_mul_f32 v[182:183], v[182:183], v[22:23]
    v_pk_mul_f32 v[82:83], v[82:83], v[26:27]
    v_cvt_pk_bf16_f32 v80, v180, v80
    v_cvt_pk_bf16_f32 v81, v181, v81
    v_cvt_pk_bf16_f32 v82, v182, v82
    v_cvt_pk_bf16_f32 v83, v183, v83
    buffer_store_dwordx4 v[80:83], v1, s[20:23], s40 offen offset:0 sc1
    s_cmp_lg_u32 s3, 0
    s_cbranch_scc1 L_nb2
    s_barrier
L_nb2:
    v_pk_mul_f32 v[184:185], v[184:185], v[20:21]
    v_pk_mul_f32 v[84:85], v[84:85], v[24:25]
    v_pk_mul_f32 v[186:187], v[186:187], v[22:23]
    v_pk_mul_f32 v[86:87], v[86:87], v[26:27]
    v_cvt_pk_bf16_f32 v84, v184, v84
    v_cvt_pk_bf16_f32 v85, v185, v85
    v_cvt_pk_bf16_f32 v86, v186, v86
    v_cvt_pk_bf16_f32 v87, v187, v87
    buffer_store_dwordx4 v[84:87], v1, s[20:23], s40 offen offset:3072 sc1
    s_addk_i32 s40, 6144
    v_pk_mul_f32 v[188:189], v[188:189], v[20:21]
    v_pk_mul_f32 v[88:89], v[88:89], v[24:25]
    v_pk_mul_f32 v[190:191], v[190:191], v[22:23]
    v_pk_mul_f32 v[90:91], v[90:91], v[26:27]
    v_cvt_pk_bf16_f32 v88, v188, v88
    v_cvt_pk_bf16_f32 v89, v189, v89
    v_cvt_pk_bf16_f32 v90, v190, v90
    v_cvt_pk_bf16_f32 v91, v191, v91
    buffer_store_dwordx4 v[88:91], v1, s[20:23], s40 offen offset:0 sc1
    v_pk_mul_f32 v[192:193], v[192:193], v[20:21]
    v_pk_mul_f32 v[92:93], v[92:93], v[24:25]
    v_pk_mul_f32 v[194:195], v[194:195], v[22:23]
    v_pk_mul_f32 v[94:95], v[94:95], v[26:27]
    v_cvt_pk_bf16_f32 v92, v192, v92
    v_cvt_pk_bf16_f32 v93, v193, v93
    v_cvt_pk_bf16_f32 v94, v194, v94
    v_cvt_pk_bf16_f32 v95, v195, v95
    buffer_store_dwordx4 v[92:95], v1, s[20:23], s40 offen offset:3072 sc1
    s_addk_i32 s40, 6144
    v_pk_mul_f32 v[196:197], v[196:197], v[20:21]
    v_pk_mul_f32 v[96:97], v[96:97], v[24:25]
    v_pk_mul_f32 v[198:199], v[198:199], v[22:23]
    v_pk_mul_f32 v[98:99], v[98:99], v[26:27]
    v_cvt_pk_bf16_f32 v96, v196, v96
    v_cvt_pk_bf16_f32 v97, v197, v97
    v_cvt_pk_bf16_f32 v98, v198, v98
    v_cvt_pk_bf16_f32 v99, v199, v99
    buffer_store_dwordx4 v[96:99], v1, s[20:23], s40 offen offset:0 sc1
    v_pk_mul_f32 v[200:201], v[200:201], v[20:21]
    v_pk_mul_f32 v[100:101], v[100:101], v[24:25]
    v_pk_mul_f32 v[202:203], v[202:203], v[22:23]
    v_pk_mul_f32 v[102:103], v[102:103], v[26:27]
    v_cvt_pk_bf16_f32 v100, v200, v100
    v_cvt_pk_bf16_f32 v101, v201, v101
    v_cvt_pk_bf16_f32 v102, v202, v102
    v_cvt_pk_bf16_f32 v103, v203, v103
    buffer_store_dwordx4 v[100:103], v1, s[20:23], s40 offen offset:3072 sc1
    s_addk_i32 s40, 6144
    v_pk_mul_f32 v[204:205], v[204:205], v[20:21]
    v_pk_mul_f32 v[104:105], v[104:105], v[24:25]
    v_pk_mul_f32 v[206:207], v[206:207], v[22:23]
    v_pk_mul_f32 v[106:107], v[106:107], v[26:27]
    v_cvt_pk_bf16_f32 v104, v204, v104
    v_cvt_pk_bf16_f32 v105, v205, v105
    v_cvt_pk_bf16_f32 v106, v206, v106
    v_cvt_pk_bf16_f32 v107, v207, v107
    buffer_store_dwordx4 v[104:107], v1, s[20:23], s40 offen offset:0 sc1
    v_pk_mul_f32 v[208:209], v[208:209], v[20:21]
    v_pk_mul_f32 v[108:109], v[108:109], v[24:25]
    v_pk_mul_f32 v[210:211], v[210:211], v[22:23]
    v_pk_mul_f32 v[110:111], v[110:111], v[26:27]
    v_cvt_pk_bf16_f32 v108, v208, v108
    v_cvt_pk_bf16_f32 v109, v209, v109
    v_cvt_pk_bf16_f32 v110, v210, v110
    v_cvt_pk_bf16_f32 v111, v211, v111
    buffer_store_dwordx4 v[108:111], v1, s[20:23], s40 offen offset:3072 sc1
    s_addk_i32 s40, 6144
    v_pk_mul_f32 v[212:213], v[212:213], v[20:21]
    v_pk_mul_f32 v[112:113], v[112:113], v[24:25]
    v_pk_mul_f32 v[214:215], v[214:215], v[22:23]
    v_pk_mul_f32 v[114:115], v[114:115], v[26:27]
    v_cvt_pk_bf16_f32 v112, v212, v112
    v_cvt_pk_bf16_f32 v113, v213, v113
    v_cvt_pk_bf16_f32 v114, v214, v114
    v_cvt_pk_bf16_f32 v115, v215, v115
    buffer_store_dwordx4 v[112:115], v1, s[20:23], s40 offen offset:0 sc1
    v_pk_mul_f32 v[216:217], v[216:217], v[20:21]
    v_pk_mul_f32 v[116:117], v[116:117], v[24:25]
    v_pk_mul_f32 v[218:219], v[218:219], v[22:23]
    v_pk_mul_f32 v[118:119], v[118:119], v[26:27]
    v_cvt_pk_bf16_f32 v116, v216, v116
    v_cvt_pk_bf16_f32 v117, v217, v117
    v_cvt_pk_bf16_f32 v118, v218, v118
    v_cvt_pk_bf16_f32 v119, v219, v119
    buffer_store_dwordx4 v[116:119], v1, s[20:23], s40 offen offset:3072 sc1
    s_addk_i32 s40, 6144
    v_pk_mul_f32 v[220:221], v[220:221], v[20:21]
    v_pk_mul_f32 v[120:121], v[120:121], v[24:25]
    v_pk_mul_f32 v[222:223], v[222:223], v[22:23]
    v_pk_mul_f32 v[122:123], v[122:123], v[26:27]
    v_cvt_pk_bf16_f32 v120, v220, v120
    v_cvt_pk_bf16_f32 v121, v221, v121
    v_cvt_pk_bf16_f32 v122, v222, v122
    v_cvt_pk_bf16_f32 v123, v223, v123
    buffer_store_dwordx4 v[120:123], v1, s[20:23], s40 offen offset:0 sc1
    v_pk_mul_f32 v[224:225], v[224:225], v[20:21]
    v_pk_mul_f32 v[124:125], v[124:125], v[24:25]
    v_pk_mul_f32 v[226:227], v[226:227], v[22:23]
    v_pk_mul_f32 v[126:127], v[126:127], v[26:27]
    v_cvt_pk_bf16_f32 v124, v224, v124
    v_cvt_pk_bf16_f32 v125, v225, v125
    v_cvt_pk_bf16_f32 v126, v226, v126
    v_cvt_pk_bf16_f32 v127, v227, v127
    buffer_store_dwordx4 v[124:127], v1, s[20:23], s40 offen offset:3072 sc1
    s_addk_i32 s40, 6144
    v_pk_mul_f32 v[228:229], v[228:229], v[20:21]
    v_pk_mul_f32 v[128:129], v[128:129], v[24:25]
    v_pk_mul_f32 v[230:231], v[230:231], v[22:23]
    v_pk_mul_f32 v[130:131], v[130:131], v[26:27]
    v_cvt_pk_bf16_f32 v128, v228, v128
    v_cvt_pk_bf16_f32 v129, v229, v129
    v_cvt_pk_bf16_f32 v130, v230, v130
    v_cvt_pk_bf16_f32 v131, v231, v131
    buffer_store_dwordx4 v[128:131], v1, s[20:23], s40 offen offset:0 sc1
    v_pk_mul_f32 v[232:233], v[232:233], v[20:21]
    v_pk_mul_f32 v[132:133], v[132:133], v[24:25]
    v_pk_mul_f32 v[234:235], v[234:235], v[22:23]
    v_pk_mul_f32 v[134:135], v[134:135], v[26:27]
    v_cvt_pk_bf16_f32 v132, v232, v132
    v_cvt_pk_bf16_f32 v133, v233, v133
    v_cvt_pk_bf16_f32 v134, v234, v134
    v_cvt_pk_bf16_f32 v135, v235, v135
    buffer_store_dwordx4 v[132:135], v1, s[20:23], s40 offen offset:3072 sc1
    s_addk_i32 s40, 6144
    v_pk_mul_f32 v[236:237], v[236:237], v[20:21]
    v_pk_mul_f32 v[136:137], v[136:137], v[24:25]
    v_pk_mul_f32 v[238:239], v[238:239], v[22:23]
    v_pk_mul_f32 v[138:139], v[138:139], v[26:27]
    v_cvt_pk_bf16_f32 v136, v236, v136
    v_cvt_pk_bf16_f32 v137, v237, v137
    v_cvt_pk_bf16_f32 v138, v238, v138
    v_cvt_pk_bf16_f32 v139, v239, v139
    buffer_store_dwordx4 v[136:139], v1, s[20:23], s40 offen offset:0 sc1
    v_pk_mul_f32 v[240:241], v[240:241], v[20:21]
    v_pk_mul_f32 v[140:141], v[140:141], v[24:25]
    v_pk_mul_f32 v[242:243], v[242:243], v[22:23]
    v_pk_mul_f32 v[142:143], v[142:143], v[26:27]
    v_cvt_pk_bf16_f32 v140, v240, v140
    v_cvt_pk_bf16_f32 v141, v241, v141
    v_cvt_pk_bf16_f32 v142, v242, v142
    v_cvt_pk_bf16_f32 v143, v243, v143
    buffer_store_dwordx4 v[140:143], v1, s[20:23], s40 offen offset:3072 sc1
    s_addk_i32 s40, 6144
    v_pk_mul_f32 v[244:245], v[244:245], v[20:21]
    v_pk_mul_f32 v[144:145], v[144:145], v[24:25]
    v_pk_mul_f32 v[246:247], v[246:247], v[22:23]
    v_pk_mul_f32 v[146:147], v[146:147], v[26:27]
    v_cvt_pk_bf16_f32 v144, v244, v144
    v_cvt_pk_bf16_f32 v145, v245, v145
    v_cvt_pk_bf16_f32 v146, v246, v146
    v_cvt_pk_bf16_f32 v147, v247, v147
    buffer_store_dwordx4 v[144:147], v1, s[20:23], s40 offen offset:0 sc1
    v_pk_mul_f32 v[248:249], v[248:249], v[20:21]
    v_pk_mul_f32 v[148:149], v[148:149], v[24:25]
    v_pk_mul_f32 v[250:251], v[250:251], v[22:23]
    v_pk_mul_f32 v[150:151], v[150:151], v[26:27]
    v_cvt_pk_bf16_f32 v148, v248, v148
    v_cvt_pk_bf16_f32 v149, v249, v149
    v_cvt_pk_bf16_f32 v150, v250, v150
    v_cvt_pk_bf16_f32 v151, v251, v151
    buffer_store_dwordx4 v[148:151], v1, s[20:23], s40 offen offset:3072 sc1
    s_addk_i32 s40, 6144
    v_pk_mul_f32 v[252:253], v[252:253], v[20:21]
    v_pk_mul_f32 v[152:153], v[152:153], v[24:25]
    v_pk_mul_f32 v[254:255], v[254:255], v[22:23]
    v_pk_mul_f32 v[154:155], v[154:155], v[26:27]
    v_cvt_pk_bf16_f32 v152, v252, v152
    v_cvt_pk_bf16_f32 v153, v253, v153
    v_cvt_pk_bf16_f32 v154, v254, v154
    v_cvt_pk_bf16_f32 v155, v255, v155
    buffer_store_dwordx4 v[152:155], v2, s[20:23], s40 offen sc1
L_end:
    s_endpgm
L_flagnext:
    s_addk_i32 s45, 64
    s_cmpk_ge_u32 s45, 256
    s_cbranch_scc1 L_flagpoll
    s_load_dword s44, s[8:9], s45
    s_waitcnt lgkmcnt(0)
    s_cmp_ge_u32 s44, 6
    s_cbranch_scc1 L_flagok
    s_branch L_flagnext
L_flagpoll:
    v_mov_b32 v6, 0
    global_load_dword v7, v6, s[8:9] sc1
    s_sub_u32 s46, s46, 1
    s_cbranch_scc1 L_flagto
    s_waitcnt vmcnt(0)
    v_cmp_le_u32 vcc, 6, v7
    s_cbranch_vccz L_flagpoll
L_flagto:
    s_mov_b32 s46, s49
    s_branch L_flagok
L_codeend:
    .fill (6400 - (L_codeend - standalone__channel_attn_eca__vision_kernel)) / 4, 4, 0xbf810000
.section .rodata,"a"
.p2align 6
.amdhsa_kernel standalone__channel_attn_eca__vision_kernel
  .amdhsa_next_free_vgpr 256
  .amdhsa_next_free_sgpr 64
  .amdhsa_accum_offset 256
  .amdhsa_group_segment_fixed_size 0
  .amdhsa_kernarg_size 40
  .amdhsa_user_sgpr_count 2
  .amdhsa_user_sgpr_kernarg_segment_ptr 1
  .amdhsa_system_sgpr_workgroup_id_x 1
  .amdhsa_float_denorm_mode_32 3
  .amdhsa_float_denorm_mode_16_64 3
.end_amdhsa_kernel
```
